```python
import torch

def _softmax(x, axis=-1):
    return torch.softmax(x, dim=axis)
def _gelu(x):
    return torch.nn.functional.gelu(x, approximate="tanh")
def _silu(x):
    return torch.nn.functional.silu(x)
def _sigmoid(x):
    return torch.sigmoid(x)
def _layernorm(x, axis=-1, eps=1e-5):
    m = x.mean(dim=axis, keepdim=True)
    v = x.var(dim=axis, keepdim=True, unbiased=False)
    return (x - m) / torch.sqrt(v + eps)
def _scatter_add(tgt, idx, src, axis=0):
    return tgt.clone().index_add_(axis, idx, src)
def _segment_sum(src, seg, n):
    out = torch.zeros((n,) + src.shape[1:], dtype=src.dtype)
    return out.index_add_(0, seg, src)
def _pad(x, pw):
    flat = tuple(v for pair in reversed(pw) for v in pair)
    return torch.nn.functional.pad(x, flat)

kernel_name = 'parallel_sum__sliding_block_cached__dense_activation_relu__decode'

def setup_inputs():

    _w = (lambda a: (lambda t: t.to(torch.bfloat16) if t.is_floating_point() else t)(torch.as_tensor(a)))
    def _A_setup():
        B, Sq, D = 1, 1, 512
        Hq, Hkv, Sk, Dh = 32, 8, 65536, 128
        assert Hq % Hkv == 0, (Hq, Hkv)
        return {
            "x": _w((lambda *s: torch.randn(*s, dtype=torch.bfloat16) * 0.05)(B, Sq, D)),
            "k_cache": _w((lambda *s: torch.randn(*s, dtype=torch.bfloat16) * 3.2)(B, Hkv, Sk, Dh)),
            "v_cache": _w((lambda *s: torch.randn(*s, dtype=torch.bfloat16) * 1.6)(B, Hkv, Sk, Dh)),
            "wq": _w((lambda *s: torch.randn(*s, dtype=torch.bfloat16) * 3.2)(D, Hq * Dh) * (D ** -0.5)),
            "wo": _w((lambda *s: torch.randn(*s, dtype=torch.bfloat16) * 1.6)(Hq * Dh, D) * ((Hq * Dh) ** -0.5)),
        }
    _A_in = _A_setup()

    def _B_setup():
        B, S, D, Dff = 1, 1, 512, 1792
        return {
            "x": _w((lambda *s: torch.randn(*s, dtype=torch.bfloat16) * 0.05)(B, S, D)),
            "w1": _w((lambda *s: torch.randn(*s, dtype=torch.bfloat16) * 0.05)(D, Dff)),
            "w2": _w((lambda *s: torch.randn(*s, dtype=torch.bfloat16) * 0.05)(Dff, D)),
        }
    _B_in = _B_setup()

    return {
        "A_x": _A_in["x"],
        "A_k_cache": _A_in["k_cache"],
        "A_v_cache": _A_in["v_cache"],
        "A_wq": _A_in["wq"],
        "A_wo": _A_in["wo"],
        "B_x": _B_in["x"],
        "B_w1": _B_in["w1"],
        "B_w2": _B_in["w2"],
    }

def reference(A_x, A_k_cache, A_v_cache, A_wq, A_wo, B_x, B_w1, B_w2):
    def _A_ref(x, k_cache, v_cache, wq, wo):
        B, Sq, D = x.shape
        Hq, Dh = 32, 128
        Hkv, Sk = k_cache.shape[1], k_cache.shape[2]
        W = min(4096, max(256, Sk // 4))
        rep = Hq // Hkv
        q = (lambda x, *d: x.permute(*d))((x @ wq).reshape(B, Sq, Hq, Dh), 0, 2, 1, 3)
        k = (lambda x, n, axis: torch.repeat_interleave(x, n, dim=axis))(k_cache[:, :, Sk - W:, :], rep, axis=1)
        v = (lambda x, n, axis: torch.repeat_interleave(x, n, dim=axis))(v_cache[:, :, Sk - W:, :], rep, axis=1)
        scores = torch.einsum("bhqd,bhkd->bhqk", q, k) * (Dh ** -0.5)
        p = _softmax(scores, axis=-1)
        o = torch.einsum("bhqk,bhkd->bhqd", p, v)
        return (lambda x, *d: x.permute(*d))(o, 0, 2, 1, 3).reshape(B, Sq, Hq * Dh) @ wo

    def _B_ref(x, w1, w2):
        h = torch.einsum("bsd,df->bsf", x, w1)
        zero = torch.zeros_like(h)
        h = torch.maximum(h, zero)
        return torch.einsum("bsf,fd->bsd", h, w2)

    x = A_x
    xn = _layernorm(x, axis=-1)
    return x + _A_ref(xn, A_k_cache, A_v_cache, A_wq, A_wo) + _B_ref(xn, B_w1, B_w2)
```

```asm
; @launch grid=(256,1,1) block=(320,1,1) lds=14336
.amdgcn_target "amdgcn-amd-amdhsa--gfx950"
.text
.globl parallel_sum__sliding_block_cached__dense_activation_relu__decode_kernel
.p2align 8
.type parallel_sum__sliding_block_cached__dense_activation_relu__decode_kernel,@function
parallel_sum__sliding_block_cached__dense_activation_relu__decode_kernel:
    s_cmp_ge_u32 s2, 256
    s_cbranch_scc1 L_end
    s_load_dwordx16 s[16:31], s[0:1], 0
    s_load_dwordx4 s[32:35], s[0:1], 64
    s_load_dwordx2 s[36:37], s[0:1], 80
    s_and_b32 s4, s2, 7
    s_lshr_b32 s5, s2, 3
    v_and_b32 v1, 63, v0
    v_lshrrev_b32 v2, 6, v0
    s_and_b32 s7, s5, 3
    v_readfirstlane_b32 s6, v2
    s_lshr_b32 s8, s5, 2
    s_lshr_b32 s45, s5, 3
    s_and_b32 s46, s5, 7
    s_lshl_b32 s47, s4, 2
    s_add_u32 s47, s47, s45
    s_mov_b32 s13, 0x05040100
    s_mov_b32 s14, 0x07060302
    s_mov_b32 s15, 0xffff0000
    s_mov_b32 s43, 0x3fb8aa3b
    s_mov_b32 s44, 0x3db504f3
    v_and_b32 v254, 15, v1
    v_lshrrev_b32 v255, 4, v1
    v_lshrrev_b32 v240, 3, v1
    v_and_b32 v241, 7, v1
    s_waitcnt lgkmcnt(0)
    s_cmp_eq_u32 s6, 4
    s_cbranch_scc1 L_poller
    v_lshlrev_b32 v2, 4, v1
    global_load_dwordx4 v[12:15], v2, s[16:17]
    s_lshl_b32 s9, s7, 7
    s_lshl_b32 s10, s6, 5
    s_add_u32 s9, s9, s10
    v_add_u32 v3, s9, v240
    v_lshlrev_b32 v4, 1, v3
    global_load_ushort v16, v4, s[16:17] offset:0
    global_load_ushort v17, v4, s[16:17] offset:16
    global_load_ushort v18, v4, s[16:17] offset:32
    global_load_ushort v19, v4, s[16:17] offset:48
    s_lshl_b32 s10, s46, 6
    s_lshl_b32 s11, s6, 4
    s_add_u32 s10, s10, s11
    v_add_u32 v5, s10, v240
    v_lshlrev_b32 v6, 1, v5
    global_load_ushort v20, v6, s[16:17] offset:0
    global_load_ushort v21, v6, s[16:17] offset:16
    s_lshl_b32 s9, s4, 10
    s_lshl_b32 s11, s8, 7
    s_add_u32 s9, s9, s11
    v_lshlrev_b32 v3, 13, v3
    v_lshl_add_u32 v3, v241, 4, v3
    v_add_u32 v3, s9, v3
    global_load_dwordx4 v[24:27], v3, s[22:23] nt
    v_add_u32 v3, 0x10000, v3
    global_load_dwordx4 v[28:31], v3, s[22:23] nt
    v_add_u32 v3, 0x10000, v3
    global_load_dwordx4 v[32:35], v3, s[22:23] nt
    v_add_u32 v3, 0x10000, v3
    global_load_dwordx4 v[36:39], v3, s[22:23] nt
    s_mul_i32 s9, s47, 112
    s_movk_i32 s11, 3584
    v_mul_u32_u24 v5, s11, v5
    v_min_u32 v6, 6, v241
    v_lshl_add_u32 v5, v6, 4, v5
    v_add_u32 v5, s9, v5
    global_load_dwordx4 v[40:43], v5, s[28:29] nt
    v_add_u32 v5, 0x7000, v5
    global_load_dwordx4 v[44:47], v5, s[28:29] nt
    s_barrier
    s_lshl_b32 s9, s4, 24
    s_lshl_b32 s10, s5, 15
    s_add_u32 s9, s9, s10
    s_lshl_b32 s10, s6, 13
    s_add_u32 s9, s9, s10
    s_add_u32 s9, s9, 15730688
    v_lshlrev_b32 v7, 8, v254
    v_lshl_add_u32 v7, v255, 4, v7
    v_add_u32 v7, s9, v7
    v_lshlrev_b32 v8, 10, v255
    v_lshl_add_u32 v8, v254, 4, v8
    v_add_u32 v8, s9, v8
    s_mul_i32 s9, s47, 56
    s_mul_i32 s10, s6, 14
    s_add_u32 s9, s9, s10
    s_lshl_b32 s9, s9, 10
    s_lshl_b32 s10, s46, 7
    s_add_u32 s9, s9, s10
    v_lshlrev_b32 v9, 10, v240
    v_lshl_add_u32 v9, v241, 4, v9
    v_add_u32 v9, s9, v9
    v_min_u32 v10, 5, v240
    v_lshlrev_b32 v10, 10, v10
    v_lshl_add_u32 v10, v241, 4, v10
    v_add_u32 v10, s9, v10
    v_add_u32 v10, 0x2000, v10
    s_lshl_b32 s9, s47, 17
    s_lshl_b32 s11, s6, 15
    s_add_u32 s9, s9, s11
    s_add_u32 s9, s9, s10
    v_lshlrev_b32 v11, 10, v240
    v_lshl_add_u32 v11, v241, 4, v11
    v_add_u32 v11, s9, v11
    s_lshl_b32 s9, s6, 9
    v_lshlrev_b32 v242, 5, v241
    v_lshl_add_u32 v242, v255, 3, v242
    v_add_u32 v242, s9, v242
    global_load_dwordx4 v[48:51], v7, s[18:19] offset:-2048 nt
    global_load_dwordx4 v[52:55], v7, s[18:19] offset:-1984 nt
    global_load_dwordx4 v[56:59], v7, s[18:19] offset:-1920 nt
    global_load_dwordx4 v[60:63], v7, s[18:19] offset:-1856 nt
    global_load_dwordx4 v[64:67], v7, s[18:19] offset:2048 nt
    global_load_dwordx4 v[68:71], v7, s[18:19] offset:2112 nt
    global_load_dwordx4 v[72:75], v7, s[18:19] offset:2176 nt
    global_load_dwordx4 v[76:79], v7, s[18:19] offset:2240 nt
    global_load_dwordx4 v[80:83], v8, s[20:21] offset:-2048 nt
    global_load_dwordx4 v[84:87], v8, s[20:21] offset:-1792 nt
    global_load_dwordx4 v[88:91], v8, s[20:21] offset:-1536 nt
    global_load_dwordx4 v[92:95], v8, s[20:21] offset:-1280 nt
    global_load_dwordx4 v[96:99], v8, s[20:21] offset:2048 nt
    global_load_dwordx4 v[100:103], v8, s[20:21] offset:2304 nt
    global_load_dwordx4 v[104:107], v8, s[20:21] offset:2560 nt
    global_load_dwordx4 v[108:111], v8, s[20:21] offset:2816 nt
    global_load_dwordx4 v[112:115], v9, s[30:31] nt
    global_load_dwordx4 v[116:119], v10, s[30:31] nt
    global_load_dwordx4 v[120:123], v11, s[24:25] nt
    v_add_u32 v11, 0x2000, v11
    global_load_dwordx4 v[124:127], v11, s[24:25] nt
    v_add_u32 v11, 0x2000, v11
    global_load_dwordx4 v[128:131], v11, s[24:25] nt
    v_add_u32 v11, 0x2000, v11
    global_load_dwordx4 v[132:135], v11, s[24:25] nt
    s_waitcnt vmcnt(34)
    v_lshlrev_b32 v136, 16, v12
    v_and_b32 v137, s15, v12
    v_lshlrev_b32 v138, 16, v13
    v_and_b32 v139, s15, v13
    v_lshlrev_b32 v140, 16, v14
    v_and_b32 v141, s15, v14
    v_lshlrev_b32 v142, 16, v15
    v_and_b32 v143, s15, v15
    v_add_f32 v144, v136, v137
    v_add_f32 v145, v138, v139
    v_add_f32 v146, v140, v141
    v_add_f32 v147, v142, v143
    v_add_f32 v144, v144, v145
    v_add_f32 v146, v146, v147
    v_add_f32 v144, v144, v146
    s_nop 1
    v_add_f32_dpp v144, v144, v144 row_ror:8 row_mask:0xf bank_mask:0xf
    s_nop 1
    v_add_f32_dpp v144, v144, v144 row_ror:4 row_mask:0xf bank_mask:0xf
    s_nop 1
    v_add_f32_dpp v144, v144, v144 row_ror:2 row_mask:0xf bank_mask:0xf
    s_nop 1
    v_add_f32_dpp v144, v144, v144 row_ror:1 row_mask:0xf bank_mask:0xf
    s_nop 1
    v_mov_b32 v244, v144
    s_nop 1
    v_permlane16_swap_b32 v144, v244
    s_nop 0
    v_add_f32 v144, v144, v244
    v_mov_b32 v244, v144
    s_nop 1
    v_permlane32_swap_b32 v144, v244
    s_nop 0
    v_add_f32 v144, v144, v244
    v_mul_f32 v144, 0x3b000000, v144
    v_sub_f32 v136, v136, v144
    v_sub_f32 v137, v137, v144
    v_sub_f32 v138, v138, v144
    v_sub_f32 v139, v139, v144
    v_sub_f32 v140, v140, v144
    v_sub_f32 v141, v141, v144
    v_sub_f32 v142, v142, v144
    v_sub_f32 v143, v143, v144
    v_mul_f32 v145, v136, v136
    v_fmac_f32 v145, v137, v137
    v_fmac_f32 v145, v138, v138
    v_fmac_f32 v145, v139, v139
    v_fmac_f32 v145, v140, v140
    v_fmac_f32 v145, v141, v141
    v_fmac_f32 v145, v142, v142
    v_fmac_f32 v145, v143, v143
    s_nop 1
    v_add_f32_dpp v145, v145, v145 row_ror:8 row_mask:0xf bank_mask:0xf
    s_nop 1
    v_add_f32_dpp v145, v145, v145 row_ror:4 row_mask:0xf bank_mask:0xf
    s_nop 1
    v_add_f32_dpp v145, v145, v145 row_ror:2 row_mask:0xf bank_mask:0xf
    s_nop 1
    v_add_f32_dpp v145, v145, v145 row_ror:1 row_mask:0xf bank_mask:0xf
    s_nop 1
    v_mov_b32 v244, v145
    s_nop 1
    v_permlane16_swap_b32 v145, v244
    s_nop 0
    v_add_f32 v145, v145, v244
    v_mov_b32 v244, v145
    s_nop 1
    v_permlane32_swap_b32 v145, v244
    s_nop 0
    v_add_f32 v145, v145, v244
    v_mul_f32 v145, 0x3b000000, v145
    v_cvt_pk_bf16_f32 v146, v144, v145
    v_lshlrev_b32 v144, 16, v146
    v_and_b32 v145, s15, v146
    v_add_f32 v145, 0x3727c5ac, v145
    v_cvt_pk_bf16_f32 v146, v145, v145
    v_lshlrev_b32 v145, 16, v146
    v_sqrt_f32 v145, v145
    s_nop 0
    v_cvt_pk_bf16_f32 v146, v145, v145
    v_lshlrev_b32 v145, 16, v146
    v_rcp_f32 v146, v145
    s_waitcnt vmcnt(28)
    v_lshlrev_b32 v148, 16, v16
    v_sub_f32 v148, v148, v144
    v_lshlrev_b32 v149, 16, v17
    v_sub_f32 v149, v149, v144
    v_lshlrev_b32 v150, 16, v18
    v_sub_f32 v150, v150, v144
    v_lshlrev_b32 v151, 16, v19
    v_sub_f32 v151, v151, v144
    v_lshlrev_b32 v152, 16, v20
    v_sub_f32 v152, v152, v144
    v_lshlrev_b32 v153, 16, v21
    v_sub_f32 v153, v153, v144
    v_cvt_pk_bf16_f32 v156, v148, v149
    v_lshlrev_b32 v148, 16, v156
    v_and_b32 v149, s15, v156
    v_cvt_pk_bf16_f32 v156, v150, v151
    v_lshlrev_b32 v150, 16, v156
    v_and_b32 v151, s15, v156
    v_cvt_pk_bf16_f32 v156, v152, v153
    v_lshlrev_b32 v152, 16, v156
    v_and_b32 v153, s15, v156
    v_mul_f32 v156, v148, v146
    v_fma_f32 v157, -v156, v145, v148
    v_fma_f32 v148, v157, v146, v156
    v_mul_f32 v156, v149, v146
    v_fma_f32 v157, -v156, v145, v149
    v_fma_f32 v149, v157, v146, v156
    v_mul_f32 v156, v150, v146
    v_fma_f32 v157, -v156, v145, v150
    v_fma_f32 v150, v157, v146, v156
    v_mul_f32 v156, v151, v146
    v_fma_f32 v157, -v156, v145, v151
    v_fma_f32 v151, v157, v146, v156
    v_mul_f32 v156, v152, v146
    v_fma_f32 v157, -v156, v145, v152
    v_fma_f32 v152, v157, v146, v156
    v_mul_f32 v156, v153, v146
    v_fma_f32 v157, -v156, v145, v153
    v_fma_f32 v153, v157, v146, v156
    v_cvt_pk_bf16_f32 v16, v148, v149
    v_cvt_pk_bf16_f32 v17, v150, v151
    v_cvt_pk_bf16_f32 v20, v152, v153
    s_waitcnt vmcnt(26)
    v_perm_b32 v136, v28, v24, s13
    v_perm_b32 v137, v28, v24, s14
    v_perm_b32 v138, v29, v25, s13
    v_perm_b32 v139, v29, v25, s14
    v_perm_b32 v140, v30, v26, s13
    v_perm_b32 v141, v30, v26, s14
    v_perm_b32 v142, v31, v27, s13
    v_perm_b32 v143, v31, v27, s14
    v_dot2_f32_bf16 v168, v136, v16, 0
    v_dot2_f32_bf16 v169, v137, v16, 0
    v_dot2_f32_bf16 v170, v138, v16, 0
    v_dot2_f32_bf16 v171, v139, v16, 0
    v_dot2_f32_bf16 v172, v140, v16, 0
    v_dot2_f32_bf16 v173, v141, v16, 0
    v_dot2_f32_bf16 v174, v142, v16, 0
    v_dot2_f32_bf16 v175, v143, v16, 0
    s_waitcnt vmcnt(24)
    v_perm_b32 v144, v36, v32, s13
    v_perm_b32 v145, v36, v32, s14
    v_perm_b32 v146, v37, v33, s13
    v_perm_b32 v147, v37, v33, s14
    v_perm_b32 v148, v38, v34, s13
    v_perm_b32 v149, v38, v34, s14
    v_perm_b32 v150, v39, v35, s13
    v_perm_b32 v151, v39, v35, s14
    v_dot2_f32_bf16 v168, v144, v17, v168
    v_dot2_f32_bf16 v169, v145, v17, v169
    v_dot2_f32_bf16 v170, v146, v17, v170
    v_dot2_f32_bf16 v171, v147, v17, v171
    v_dot2_f32_bf16 v172, v148, v17, v172
    v_dot2_f32_bf16 v173, v149, v17, v173
    v_dot2_f32_bf16 v174, v150, v17, v174
    v_dot2_f32_bf16 v175, v151, v17, v175
    s_nop 2
    v_permlane32_swap_b32 v168, v172
    v_permlane32_swap_b32 v169, v173
    v_permlane32_swap_b32 v170, v174
    v_permlane32_swap_b32 v171, v175
    s_nop 0
    v_add_f32 v168, v168, v172
    v_add_f32 v169, v169, v173
    v_add_f32 v170, v170, v174
    v_add_f32 v171, v171, v175
    s_nop 1
    v_permlane16_swap_b32 v168, v170
    v_permlane16_swap_b32 v169, v171
    s_nop 0
    v_add_f32 v168, v168, v170
    v_add_f32 v169, v169, v171
    s_nop 1
    v_add_f32_dpp v168, v168, v168 row_ror:8 row_mask:0xf bank_mask:0xf
    v_add_f32_dpp v169, v169, v169 row_ror:8 row_mask:0xf bank_mask:0xf
    s_nop 0
    ds_write_b64 v242, v[168:169] offset:0
    s_waitcnt vmcnt(22)
    v_perm_b32 v136, v44, v40, s13
    v_perm_b32 v137, v44, v40, s14
    v_perm_b32 v138, v45, v41, s13
    v_perm_b32 v139, v45, v41, s14
    v_perm_b32 v140, v46, v42, s13
    v_perm_b32 v141, v46, v42, s14
    v_perm_b32 v142, v47, v43, s13
    v_perm_b32 v143, v47, v43, s14
    v_dot2_f32_bf16 v176, v136, v20, 0
    v_dot2_f32_bf16 v177, v137, v20, 0
    v_dot2_f32_bf16 v178, v138, v20, 0
    v_dot2_f32_bf16 v179, v139, v20, 0
    v_dot2_f32_bf16 v180, v140, v20, 0
    v_dot2_f32_bf16 v181, v141, v20, 0
    v_dot2_f32_bf16 v182, v142, v20, 0
    v_dot2_f32_bf16 v183, v143, v20, 0
    s_nop 2
    v_permlane32_swap_b32 v176, v180
    v_permlane32_swap_b32 v177, v181
    v_permlane32_swap_b32 v178, v182
    v_permlane32_swap_b32 v179, v183
    s_nop 0
    v_add_f32 v176, v176, v180
    v_add_f32 v177, v177, v181
    v_add_f32 v178, v178, v182
    v_add_f32 v179, v179, v183
    s_nop 1
    v_permlane16_swap_b32 v176, v178
    v_permlane16_swap_b32 v177, v179
    s_nop 0
    v_add_f32 v176, v176, v178
    v_add_f32 v177, v177, v179
    s_nop 1
    v_add_f32_dpp v176, v176, v176 row_ror:8 row_mask:0xf bank_mask:0xf
    v_add_f32_dpp v177, v177, v177 row_ror:8 row_mask:0xf bank_mask:0xf
    s_nop 0
    ds_write_b64 v242, v[176:177] offset:256
    v_mov_b32 v2, 0
    v_mov_b32 v3, 1
    s_waitcnt lgkmcnt(0)
    s_mov_b64 exec, 1
    ds_add_u32 v2, v3 offset:2064
    s_mov_b64 exec, -1
    s_waitcnt vmcnt(0)
    v_and_b32 v2, 3, v1
    v_lshlrev_b32 v2, 8, v2
    v_lshl_add_u32 v2, v255, 4, v2
    s_lshl_b32 s9, s6, 5
    v_lshlrev_b32 v3, 3, v1
    v_add_u32 v3, s9, v3
    s_lshl_b32 s9, s6, 11
    v_lshlrev_b32 v4, 7, v1
    v_add_u32 v4, s9, v4
    v_mov_b32 v5, 0
    s_mov_b32 s42, 400000
L_nz_loop:
    ds_read_b32 v247, v5 offset:2056
    s_waitcnt lgkmcnt(0)
    v_readfirstlane_b32 s9, v247
    s_sub_u32 s42, s42, 1
    s_cbranch_scc1 L_nz_done
    s_cmp_eq_u32 s9, 0
    s_cbranch_scc1 L_nz_loop
L_nz_done:
    ds_read_b128 v[228:231], v5 offset:2048
    s_lshl_b32 s9, s4, 14
    s_lshl_b32 s10, s6, 10
    s_add_u32 s9, s9, s10
    v_lshlrev_b32 v6, 4, v1
    v_add_u32 v6, s9, v6
    v_add_u32 v7, 0x2000, v6
    v_add_u32 v8, 0x200000, v6
    v_add_u32 v9, 0x200000, v7
    s_waitcnt lgkmcnt(0)
    v_add_u32 v10, 0x1000, v6
    v_add_u32 v11, 0x1000, v7
    v_add_u32 v250, 0x1000, v8
    v_add_u32 v251, 0x1000, v9
    s_mov_b32 s42, 400000
L_cq_loop:
    global_load_dwordx4 v[24:27], v6, s[36:37] sc1
    global_load_dwordx4 v[28:31], v10, s[36:37] sc1
    global_load_dwordx4 v[32:35], v7, s[36:37] sc1
    global_load_dwordx4 v[36:39], v11, s[36:37] sc1
    s_waitcnt vmcnt(0)
    v_xor_b32 v245, v26, v230
    v_xor_b32 v246, v27, v231
    v_or_b32 v244, v245, v246
    v_xor_b32 v245, v30, v230
    v_xor_b32 v246, v31, v231
    v_or3_b32 v244, v244, v245, v246
    v_xor_b32 v245, v34, v230
    v_xor_b32 v246, v35, v231
    v_or3_b32 v244, v244, v245, v246
    v_xor_b32 v245, v38, v230
    v_xor_b32 v246, v39, v231
    v_or3_b32 v244, v244, v245, v246
    v_cmp_ne_u32 vcc, 0, v244
    s_sub_u32 s42, s42, 1
    s_cbranch_scc1 L_cq_done
    s_cmp_eq_u64 vcc, 0
    s_cbranch_scc1 L_cq_done
    s_and_b32 s11, s42, 15
    s_cbranch_scc1 L_cq_loop
    global_load_dwordx4 v[168:171], v8, s[36:37] sc1
    global_load_dwordx4 v[172:175], v250, s[36:37] sc1
    global_load_dwordx4 v[176:179], v9, s[36:37] sc1
    global_load_dwordx4 v[180:183], v251, s[36:37] sc1
    s_waitcnt vmcnt(0)
    v_xor_b32 v244, v170, v230
    v_xor_b32 v245, v171, v231
    v_or_b32 v244, v244, v245
    v_cmp_eq_u32 vcc, 0, v244
    s_nop 1
    v_cndmask_b32 v24, v24, v168, vcc
    v_cndmask_b32 v25, v25, v169, vcc
    v_cndmask_b32 v26, v26, v170, vcc
    v_cndmask_b32 v27, v27, v171, vcc
    v_xor_b32 v244, v174, v230
    v_xor_b32 v245, v175, v231
    v_or_b32 v244, v244, v245
    v_cmp_eq_u32 vcc, 0, v244
    s_nop 1
    v_cndmask_b32 v28, v28, v172, vcc
    v_cndmask_b32 v29, v29, v173, vcc
    v_cndmask_b32 v30, v30, v174, vcc
    v_cndmask_b32 v31, v31, v175, vcc
    v_xor_b32 v244, v178, v230
    v_xor_b32 v245, v179, v231
    v_or_b32 v244, v244, v245
    v_cmp_eq_u32 vcc, 0, v244
    s_nop 1
    v_cndmask_b32 v32, v32, v176, vcc
    v_cndmask_b32 v33, v33, v177, vcc
    v_cndmask_b32 v34, v34, v178, vcc
    v_cndmask_b32 v35, v35, v179, vcc
    v_xor_b32 v244, v182, v230
    v_xor_b32 v245, v183, v231
    v_or_b32 v244, v244, v245
    v_cmp_eq_u32 vcc, 0, v244
    s_nop 1
    v_cndmask_b32 v36, v36, v180, vcc
    v_cndmask_b32 v37, v37, v181, vcc
    v_cndmask_b32 v38, v38, v182, vcc
    v_cndmask_b32 v39, v39, v183, vcc
    v_xor_b32 v245, v26, v230
    v_xor_b32 v246, v27, v231
    v_or_b32 v244, v245, v246
    v_xor_b32 v245, v30, v230
    v_xor_b32 v246, v31, v231
    v_or3_b32 v244, v244, v245, v246
    v_xor_b32 v245, v34, v230
    v_xor_b32 v246, v35, v231
    v_or3_b32 v244, v244, v245, v246
    v_xor_b32 v245, v38, v230
    v_xor_b32 v246, v39, v231
    v_or3_b32 v244, v244, v245, v246
    v_cmp_ne_u32 vcc, 0, v244
    s_cmp_lg_u64 vcc, 0
    s_cbranch_scc1 L_cq_loop
L_cq_done:
    v_add_f32 v24, v24, v28
    v_add_f32 v32, v32, v36
    v_add_f32 v25, v25, v29
    v_add_f32 v33, v33, v37
    v_add_f32 v24, v24, v32
    v_add_f32 v25, v25, v33
    v_cvt_pk_bf16_f32 v26, v24, v25
    s_lshl_b32 s9, s6, 8
    v_lshlrev_b32 v6, 2, v1
    v_add_u32 v6, s9, v6
    ds_write_b32 v6, v26 offset:2176
    s_waitcnt lgkmcnt(0)
    s_barrier
    ds_read_b128 v[212:215], v2 offset:2176
    ds_read_b128 v[216:219], v2 offset:2240
    ds_read_b128 v[220:223], v2 offset:2304
    ds_read_b128 v[224:227], v2 offset:2368
    s_waitcnt lgkmcnt(0)
    v_mfma_f32_16x16x32_bf16 v[200:203], v[48:51], v[212:215], 0
    v_mfma_f32_16x16x32_bf16 v[200:203], v[52:55], v[216:219], v[200:203]
    v_mfma_f32_16x16x32_bf16 v[200:203], v[56:59], v[220:223], v[200:203]
    v_mfma_f32_16x16x32_bf16 v[200:203], v[60:63], v[224:227], v[200:203]
    v_mfma_f32_16x16x32_bf16 v[204:207], v[64:67], v[212:215], 0
    v_mfma_f32_16x16x32_bf16 v[204:207], v[68:71], v[216:219], v[204:207]
    v_mfma_f32_16x16x32_bf16 v[204:207], v[72:75], v[220:223], v[204:207]
    v_mfma_f32_16x16x32_bf16 v[204:207], v[76:79], v[224:227], v[204:207]
    v_mov_b32 v234, v230
    v_mov_b32 v235, v231
    v_perm_b32 v136, v84, v80, s13
    v_perm_b32 v137, v92, v88, s13
    v_perm_b32 v138, v100, v96, s13
    v_perm_b32 v139, v108, v104, s13
    v_perm_b32 v140, v84, v80, s14
    v_perm_b32 v141, v92, v88, s14
    v_perm_b32 v142, v100, v96, s14
    v_perm_b32 v143, v108, v104, s14
    v_perm_b32 v144, v85, v81, s13
    v_perm_b32 v145, v93, v89, s13
    v_perm_b32 v146, v101, v97, s13
    v_perm_b32 v147, v109, v105, s13
    v_perm_b32 v148, v85, v81, s14
    v_perm_b32 v149, v93, v89, s14
    v_perm_b32 v150, v101, v97, s14
    v_perm_b32 v151, v109, v105, s14
    v_perm_b32 v152, v86, v82, s13
    v_perm_b32 v153, v94, v90, s13
    v_perm_b32 v154, v102, v98, s13
    v_perm_b32 v155, v110, v106, s13
    v_perm_b32 v156, v86, v82, s14
    v_perm_b32 v157, v94, v90, s14
    v_perm_b32 v158, v102, v98, s14
    v_perm_b32 v159, v110, v106, s14
    v_perm_b32 v160, v87, v83, s13
    v_perm_b32 v161, v95, v91, s13
    v_perm_b32 v162, v103, v99, s13
    v_perm_b32 v163, v111, v107, s13
    v_perm_b32 v164, v87, v83, s14
    v_perm_b32 v165, v95, v91, s14
    v_perm_b32 v166, v103, v99, s14
    v_perm_b32 v167, v111, v107, s14
    v_cvt_pk_bf16_f32 v212, v200, v201
    v_lshlrev_b32 v200, 16, v212
    v_and_b32 v201, s15, v212
    v_cvt_pk_bf16_f32 v213, v202, v203
    v_lshlrev_b32 v202, 16, v213
    v_and_b32 v203, s15, v213
    v_cvt_pk_bf16_f32 v214, v204, v205
    v_lshlrev_b32 v204, 16, v214
    v_and_b32 v205, s15, v214
    v_cvt_pk_bf16_f32 v215, v206, v207
    v_lshlrev_b32 v206, 16, v215
    v_and_b32 v207, s15, v215
    v_mul_f32 v200, s44, v200
    v_mul_f32 v201, s44, v201
    v_mul_f32 v202, s44, v202
    v_mul_f32 v203, s44, v203
    v_mul_f32 v204, s44, v204
    v_mul_f32 v205, s44, v205
    v_mul_f32 v206, s44, v206
    v_mul_f32 v207, s44, v207
    v_cvt_pk_bf16_f32 v212, v200, v201
    v_lshlrev_b32 v200, 16, v212
    v_and_b32 v201, s15, v212
    v_cvt_pk_bf16_f32 v213, v202, v203
    v_lshlrev_b32 v202, 16, v213
    v_and_b32 v203, s15, v213
    v_cvt_pk_bf16_f32 v214, v204, v205
    v_lshlrev_b32 v204, 16, v214
    v_and_b32 v205, s15, v214
    v_cvt_pk_bf16_f32 v215, v206, v207
    v_lshlrev_b32 v206, 16, v215
    v_and_b32 v207, s15, v215
    v_max3_f32 v252, v200, v201, v202
    v_max3_f32 v252, v252, v203, v204
    v_max3_f32 v252, v252, v205, v206
    v_max_f32 v252, v252, v207
    v_mov_b32 v244, v252
    s_nop 1
    v_permlane16_swap_b32 v252, v244
    s_nop 0
    v_max_f32 v252, v252, v244
    v_mov_b32 v244, v252
    s_nop 1
    v_permlane32_swap_b32 v252, v244
    s_nop 0
    v_max_f32 v252, v252, v244
    v_sub_f32 v200, v200, v252
    v_sub_f32 v201, v201, v252
    v_sub_f32 v202, v202, v252
    v_sub_f32 v203, v203, v252
    v_sub_f32 v204, v204, v252
    v_sub_f32 v205, v205, v252
    v_sub_f32 v206, v206, v252
    v_sub_f32 v207, v207, v252
    v_mul_f32 v200, s43, v200
    v_mul_f32 v201, s43, v201
    v_mul_f32 v202, s43, v202
    v_mul_f32 v203, s43, v203
    v_mul_f32 v204, s43, v204
    v_mul_f32 v205, s43, v205
    v_mul_f32 v206, s43, v206
    v_mul_f32 v207, s43, v207
    v_exp_f32 v200, v200
    v_exp_f32 v201, v201
    v_exp_f32 v202, v202
    v_exp_f32 v203, v203
    v_exp_f32 v204, v204
    v_exp_f32 v205, v205
    v_exp_f32 v206, v206
    v_exp_f32 v207, v207
    s_nop 0
    v_cvt_pk_bf16_f32 v208, v200, v201
    v_cvt_pk_bf16_f32 v209, v202, v203
    v_cvt_pk_bf16_f32 v210, v204, v205
    v_cvt_pk_bf16_f32 v211, v206, v207
    s_nop 1
    v_mfma_f32_16x16x32_bf16 v[168:171], v[208:211], v[136:139], 0
    v_mfma_f32_16x16x32_bf16 v[172:175], v[208:211], v[140:143], 0
    v_mfma_f32_16x16x32_bf16 v[176:179], v[208:211], v[144:147], 0
    v_mfma_f32_16x16x32_bf16 v[180:183], v[208:211], v[148:151], 0
    v_mfma_f32_16x16x32_bf16 v[184:187], v[208:211], v[152:155], 0
    v_mfma_f32_16x16x32_bf16 v[188:191], v[208:211], v[156:159], 0
    v_mfma_f32_16x16x32_bf16 v[192:195], v[208:211], v[160:163], 0
    v_mfma_f32_16x16x32_bf16 v[196:199], v[208:211], v[164:167], 0
    v_add_f32 v253, v200, v201
    v_add_f32 v253, v253, v202
    v_add_f32 v253, v253, v203
    v_add_f32 v253, v253, v204
    v_add_f32 v253, v253, v205
    v_add_f32 v253, v253, v206
    v_add_f32 v253, v253, v207
    v_mov_b32 v244, v253
    s_nop 1
    v_permlane16_swap_b32 v253, v244
    s_nop 0
    v_add_f32 v253, v253, v244
    v_mov_b32 v244, v253
    s_nop 1
    v_permlane32_swap_b32 v253, v244
    s_nop 0
    v_add_f32 v253, v253, v244
    s_mov_b64 exec, 15
    ds_write_b64 v3, v[252:253] offset:3584
    s_mov_b64 exec, 0xffff
    ds_write_b128 v4, v[168:171] offset:6144
    ds_write_b128 v4, v[172:175] offset:6160
    ds_write_b128 v4, v[176:179] offset:6176
    ds_write_b128 v4, v[180:183] offset:6192
    ds_write_b128 v4, v[184:187] offset:6208
    ds_write_b128 v4, v[188:191] offset:6224
    ds_write_b128 v4, v[192:195] offset:6240
    ds_write_b128 v4, v[196:199] offset:6256
    s_mov_b64 exec, -1
    v_and_b32 v2, 3, v1
    v_lshrrev_b32 v3, 2, v1
    s_lshl_b32 s9, s6, 4
    v_add_u32 v3, s9, v3
    v_lshlrev_b32 v4, 3, v2
    v_lshlrev_b32 v5, 5, v3
    v_lshl_add_u32 v5, v2, 2, v5
    v_add_u32 v6, 6144, v5
    v_add_u32 v7, 8192, v5
    v_add_u32 v8, 10240, v5
    v_add_u32 v9, 12288, v5
    v_lshrrev_b32 v10, 3, v3
    v_lshl_add_u32 v10, v2, 3, v10
    v_lshlrev_b32 v10, 15, v10
    v_and_b32 v5, 7, v3
    v_lshl_add_u32 v10, v5, 4, v10
    s_lshl_b32 s9, s4, 12
    s_lshl_b32 s10, s5, 7
    s_add_u32 s9, s9, s10
    s_add_u32 s9, s9, 1048576
    v_add_u32 v10, s9, v10
    s_lshl_b32 s9, s4, 11
    s_lshl_b32 s10, s5, 4
    s_add_u32 s9, s9, s10
    s_add_u32 s9, s9, 262144
    v_lshlrev_b32 v5, 9, v2
    v_add_u32 v5, s9, v5
    s_waitcnt lgkmcnt(0)
    s_barrier
    ds_read_b64 v[212:213], v4 offset:3584
    ds_read_b64 v[214:215], v4 offset:3616
    ds_read_b64 v[216:217], v4 offset:3648
    ds_read_b64 v[218:219], v4 offset:3680
    ds_read2_b32 v[220:221], v6 offset0:0 offset1:4
    ds_read2_b32 v[222:223], v7 offset0:0 offset1:4
    ds_read2_b32 v[224:225], v8 offset0:0 offset1:4
    ds_read2_b32 v[226:227], v9 offset0:0 offset1:4
    s_waitcnt lgkmcnt(4)
    v_max_f32 v200, v212, v214
    v_max3_f32 v200, v200, v216, v218
    v_sub_f32 v201, v212, v200
    v_mul_f32 v201, s43, v201
    v_sub_f32 v202, v214, v200
    v_mul_f32 v202, s43, v202
    v_sub_f32 v203, v216, v200
    v_mul_f32 v203, s43, v203
    v_sub_f32 v204, v218, v200
    v_mul_f32 v204, s43, v204
    v_exp_f32 v201, v201
    v_exp_f32 v202, v202
    v_exp_f32 v203, v203
    v_exp_f32 v204, v204
    s_waitcnt lgkmcnt(0)
    v_mul_f32 v228, v201, v220
    v_mul_f32 v229, v201, v221
    v_mul_f32 v233, v201, v213
    v_fmac_f32 v228, v202, v222
    v_fmac_f32 v229, v202, v223
    v_fmac_f32 v233, v202, v215
    v_fmac_f32 v228, v203, v224
    v_fmac_f32 v229, v203, v225
    v_fmac_f32 v233, v203, v217
    v_fmac_f32 v228, v204, v226
    v_fmac_f32 v229, v204, v227
    v_fmac_f32 v233, v204, v219
    v_mov_b32 v232, v200
    global_store_dwordx4 v10, v[228:231], s[36:37]
    s_cmp_lg_u32 s6, 0
    s_cbranch_scc1 L_nomlpub
    s_mov_b64 exec, 15
    global_store_dwordx4 v5, v[232:235], s[36:37]
    s_mov_b64 exec, -1
L_nomlpub:
    v_add_u32 v10, 0x200000, v10
    v_add_u32 v5, 0x200000, v5
    v_perm_b32 v80, v116, v112, s13
    v_perm_b32 v81, v116, v112, s14
    v_perm_b32 v82, v117, v113, s13
    v_perm_b32 v83, v117, v113, s14
    v_perm_b32 v84, v118, v114, s13
    v_perm_b32 v85, v118, v114, s14
    v_perm_b32 v86, v119, v115, s13
    v_perm_b32 v87, v119, v115, s14
    v_perm_b32 v88, v124, v120, s13
    v_perm_b32 v89, v124, v120, s14
    v_perm_b32 v90, v125, v121, s13
    v_perm_b32 v91, v125, v121, s14
    v_perm_b32 v92, v126, v122, s13
    v_perm_b32 v93, v126, v122, s14
    v_perm_b32 v94, v127, v123, s13
    v_perm_b32 v95, v127, v123, s14
    v_perm_b32 v96, v132, v128, s13
    v_perm_b32 v97, v132, v128, s14
    v_perm_b32 v98, v133, v129, s13
    v_perm_b32 v99, v133, v129, s14
    v_perm_b32 v100, v134, v130, s13
    v_perm_b32 v101, v134, v130, s14
    v_perm_b32 v102, v135, v131, s13
    v_perm_b32 v103, v135, v131, s14
    s_mul_i32 s9, s6, 28
    v_lshlrev_b32 v2, 1, v240
    v_add_u32 v2, s9, v2
    ds_read_u16 v166, v2 offset:3200
    ds_read_u16 v167, v2 offset:3216
    v_cmp_gt_u32 vcc, 6, v240
    s_waitcnt lgkmcnt(0)
    v_lshl_or_b32 v167, v167, 16, v166
    v_cndmask_b32 v167, v166, v167, vcc
    v_dot2_f32_bf16 v176, v80, v167, 0
    v_dot2_f32_bf16 v177, v81, v167, 0
    v_dot2_f32_bf16 v178, v82, v167, 0
    v_dot2_f32_bf16 v179, v83, v167, 0
    v_dot2_f32_bf16 v180, v84, v167, 0
    v_dot2_f32_bf16 v181, v85, v167, 0
    v_dot2_f32_bf16 v182, v86, v167, 0
    v_dot2_f32_bf16 v183, v87, v167, 0
    s_nop 2
    v_permlane32_swap_b32 v176, v180
    v_permlane32_swap_b32 v177, v181
    v_permlane32_swap_b32 v178, v182
    v_permlane32_swap_b32 v179, v183
    s_nop 0
    v_add_f32 v176, v176, v180
    v_add_f32 v177, v177, v181
    v_add_f32 v178, v178, v182
    v_add_f32 v179, v179, v183
    s_nop 1
    v_permlane16_swap_b32 v176, v178
    v_permlane16_swap_b32 v177, v179
    s_nop 0
    v_add_f32 v176, v176, v178
    v_add_f32 v177, v177, v179
    s_nop 1
    v_add_f32_dpp v176, v176, v176 row_ror:8 row_mask:0xf bank_mask:0xf
    v_add_f32_dpp v177, v177, v177 row_ror:8 row_mask:0xf bank_mask:0xf
    s_nop 0
    s_lshl_b32 s9, s6, 8
    v_subrev_u32 v3, s9, v242
    ds_write_b64 v3, v[176:177] offset:4736
    s_lshl_b32 s9, s6, 6
    v_lshlrev_b32 v2, 1, v240
    v_add_u32 v2, s9, v2
    global_store_dwordx4 v10, v[228:231], s[36:37] sc1
    s_cmp_lg_u32 s6, 0
    s_cbranch_scc1 L_nomlpub2
    s_mov_b64 exec, 15
    global_store_dwordx4 v5, v[232:235], s[36:37] sc1
    s_mov_b64 exec, -1
L_nomlpub2:
    s_barrier
    ds_read_u16 v152, v2 offset:3328
    ds_read_u16 v154, v2 offset:3344
    ds_read_u16 v153, v2 offset:3360
    ds_read_u16 v155, v2 offset:3376
    s_waitcnt lgkmcnt(0)
    v_lshl_or_b32 v152, v154, 16, v152
    v_lshl_or_b32 v153, v155, 16, v153
    v_dot2_f32_bf16 v168, v88, v152, 0
    v_dot2_f32_bf16 v169, v89, v152, 0
    v_dot2_f32_bf16 v170, v90, v152, 0
    v_dot2_f32_bf16 v171, v91, v152, 0
    v_dot2_f32_bf16 v172, v92, v152, 0
    v_dot2_f32_bf16 v173, v93, v152, 0
    v_dot2_f32_bf16 v174, v94, v152, 0
    v_dot2_f32_bf16 v175, v95, v152, 0
    v_dot2_f32_bf16 v168, v96, v153, v168
    v_dot2_f32_bf16 v169, v97, v153, v169
    v_dot2_f32_bf16 v170, v98, v153, v170
    v_dot2_f32_bf16 v171, v99, v153, v171
    v_dot2_f32_bf16 v172, v100, v153, v172
    v_dot2_f32_bf16 v173, v101, v153, v173
    v_dot2_f32_bf16 v174, v102, v153, v174
    v_dot2_f32_bf16 v175, v103, v153, v175
    s_nop 2
    v_permlane32_swap_b32 v168, v172
    v_permlane32_swap_b32 v169, v173
    v_permlane32_swap_b32 v170, v174
    v_permlane32_swap_b32 v171, v175
    s_nop 0
    v_add_f32 v168, v168, v172
    v_add_f32 v169, v169, v173
    v_add_f32 v170, v170, v174
    v_add_f32 v171, v171, v175
    s_nop 1
    v_permlane16_swap_b32 v168, v170
    v_permlane16_swap_b32 v169, v171
    s_nop 0
    v_add_f32 v168, v168, v170
    v_add_f32 v169, v169, v171
    s_nop 1
    v_add_f32_dpp v168, v168, v168 row_ror:8 row_mask:0xf bank_mask:0xf
    v_add_f32_dpp v169, v169, v169 row_ror:8 row_mask:0xf bank_mask:0xf
    s_nop 0
    ds_write_b64 v3, v[168:169] offset:3712
    s_waitcnt lgkmcnt(0)
    s_barrier
    s_endpgm
L_poller:
    v_mov_b32 v6, 0
    ds_write_b32 v6, v6 offset:2064
    ds_write_b32 v6, v6 offset:2056
    s_lshl_b32 s12, s2, 2
    v_mov_b32 v7, s12
    global_load_dword v8, v7, s[16:17]
    s_cmp_lg_u32 s2, 0
    s_cbranch_scc1 L_nonce_poll
    s_memrealtime s[40:41]
    s_waitcnt lgkmcnt(0)
    s_or_b32 s40, s40, 1
    v_mov_b32 v4, s40
    v_mov_b32 v5, s41
    s_mov_b64 exec, 1
    global_store_dwordx2 v6, v[4:5], s[34:35] sc1
    s_mov_b64 exec, -1
L_nonce_poll:
    s_waitcnt lgkmcnt(0)
    s_barrier
    s_mov_b32 s42, 400000
L_nonce_loop:
    s_mov_b64 exec, 1
    global_load_dwordx2 v[4:5], v6, s[34:35] sc1
    s_waitcnt vmcnt(0)
    v_readlane_b32 s9, v4, 0
    v_readlane_b32 s10, v5, 0
    s_sub_u32 s42, s42, 1
    s_cbranch_scc1 L_nonce_done
    s_cmp_eq_u32 s9, 0
    s_cbranch_scc1 L_nonce_loop
L_nonce_done:
    s_mov_b64 exec, -1
    v_mov_b32 v4, s9
    v_mov_b32 v5, s10
    ds_write_b64 v6, v[4:5] offset:2056
    s_lshl_b32 s9, s4, 2
    s_add_u32 s9, s9, s7
    s_lshl_b32 s9, s9, 12
    s_lshl_b32 s10, s8, 9
    s_add_u32 s9, s9, s10
    s_lshl_b32 s10, s47, 3
    s_add_u32 s10, s10, s46
    s_lshl_b32 s10, s10, 9
    s_add_u32 s10, s10, 130560
    v_lshlrev_b32 v7, 4, v1
    v_add_u32 v12, s9, v7
    v_add_u32 v13, s10, v7
    v_cmp_gt_u32 vcc, 32, v1
    s_nop 1
    v_cndmask_b32 v12, v13, v12, vcc
    v_lshlrev_b32 v9, 3, v1
    s_mov_b32 s42, 400000
L_cnt_loop:
    ds_read_b32 v3, v6 offset:2064
    s_waitcnt lgkmcnt(0)
    v_readfirstlane_b32 s9, v3
    s_sub_u32 s42, s42, 1
    s_cbranch_scc1 L_cnt_done
    s_cmp_lg_u32 s9, 4
    s_cbranch_scc1 L_cnt_loop
L_cnt_done:
    ds_read_b64 v[16:17], v9 offset:0
    ds_read_b64 v[18:19], v9 offset:512
    ds_read_b64 v[20:21], v9 offset:1024
    ds_read_b64 v[22:23], v9 offset:1536
    s_waitcnt lgkmcnt(0)
    v_add_f32 v16, v16, v18
    v_add_f32 v20, v20, v22
    v_add_f32 v17, v17, v19
    v_add_f32 v21, v21, v23
    v_add_f32 v16, v16, v20
    v_add_f32 v17, v17, v21
    v_mov_b32 v18, v4
    v_mov_b32 v19, v5
    s_mov_b32 exec_hi, 0x0fffffff
    v_add_u32 v13, 0x200000, v12
    global_store_dwordx4 v12, v[16:19], s[36:37]
    global_store_dwordx4 v13, v[16:19], s[36:37] sc1
    s_mov_b64 exec, 1
    v_mov_b32 v3, 1
    ds_add_u32 v6, v3 offset:2064
    s_mov_b64 exec, -1
    s_barrier
    s_lshl_b32 s9, s47, 12
    s_add_u32 s9, s9, 131072
    v_add_u32 v188, s9, v7
    v_add_u32 v189, 0x200000, v188
    v_mov_b32 v82, v4
    v_mov_b32 v83, v5
    v_mov_b32 v86, v4
    v_mov_b32 v87, v5
    v_mov_b32 v90, v4
    v_mov_b32 v91, v5
    v_mov_b32 v94, v4
    v_mov_b32 v95, v5
    v_mov_b32 v98, v4
    v_mov_b32 v99, v5
    v_mov_b32 v102, v4
    v_mov_b32 v103, v5
    v_mov_b32 v106, v4
    v_mov_b32 v107, v5
    v_mov_b32 v110, v4
    v_mov_b32 v111, v5
    v_mov_b32 v114, v4
    v_mov_b32 v115, v5
    v_mov_b32 v118, v4
    v_mov_b32 v119, v5
    v_mov_b32 v122, v4
    v_mov_b32 v123, v5
    v_mov_b32 v126, v4
    v_mov_b32 v127, v5
    v_mov_b32 v130, v4
    v_mov_b32 v131, v5
    v_mov_b32 v134, v4
    v_mov_b32 v135, v5
    v_mov_b32 v138, v4
    v_mov_b32 v139, v5
    v_mov_b32 v142, v4
    v_mov_b32 v143, v5
    s_mov_b32 s42, 400000
L_h_loop:
    s_mov_b64 exec, 0xfffffff
    global_load_dwordx4 v[80:83], v188, s[36:37] offset:0 sc1
    global_load_dwordx4 v[84:87], v188, s[36:37] offset:512 sc1
    global_load_dwordx4 v[88:91], v188, s[36:37] offset:1024 sc1
    global_load_dwordx4 v[92:95], v188, s[36:37] offset:1536 sc1
    global_load_dwordx4 v[96:99], v188, s[36:37] offset:2048 sc1
    global_load_dwordx4 v[100:103], v188, s[36:37] offset:2560 sc1
    global_load_dwordx4 v[104:107], v188, s[36:37] offset:3072 sc1
    global_load_dwordx4 v[108:111], v188, s[36:37] offset:3584 sc1
    s_mov_b64 exec, -1
    s_waitcnt vmcnt(0)
    v_xor_b32 v11, v82, v4
    v_xor_b32 v3, v83, v5
    v_or_b32 v10, v11, v3
    v_xor_b32 v11, v86, v4
    v_xor_b32 v3, v87, v5
    v_or3_b32 v10, v10, v11, v3
    v_xor_b32 v11, v90, v4
    v_xor_b32 v3, v91, v5
    v_or3_b32 v10, v10, v11, v3
    v_xor_b32 v11, v94, v4
    v_xor_b32 v3, v95, v5
    v_or3_b32 v10, v10, v11, v3
    v_xor_b32 v11, v98, v4
    v_xor_b32 v3, v99, v5
    v_or3_b32 v10, v10, v11, v3
    v_xor_b32 v11, v102, v4
    v_xor_b32 v3, v103, v5
    v_or3_b32 v10, v10, v11, v3
    v_xor_b32 v11, v106, v4
    v_xor_b32 v3, v107, v5
    v_or3_b32 v10, v10, v11, v3
    v_xor_b32 v11, v110, v4
    v_xor_b32 v3, v111, v5
    v_or3_b32 v10, v10, v11, v3
    v_cmp_ne_u32 vcc, 0, v10
    s_sub_u32 s42, s42, 1
    s_cbranch_scc1 L_h_done
    s_cmp_eq_u64 vcc, 0
    s_cbranch_scc1 L_h_done
    s_and_b32 s11, s42, 15
    s_cbranch_scc1 L_h_loop
    s_mov_b64 exec, 0xfffffff
    global_load_dwordx4 v[112:115], v189, s[36:37] offset:0 sc1
    global_load_dwordx4 v[116:119], v189, s[36:37] offset:512 sc1
    global_load_dwordx4 v[120:123], v189, s[36:37] offset:1024 sc1
    global_load_dwordx4 v[124:127], v189, s[36:37] offset:1536 sc1
    global_load_dwordx4 v[128:131], v189, s[36:37] offset:2048 sc1
    global_load_dwordx4 v[132:135], v189, s[36:37] offset:2560 sc1
    global_load_dwordx4 v[136:139], v189, s[36:37] offset:3072 sc1
    global_load_dwordx4 v[140:143], v189, s[36:37] offset:3584 sc1
    s_mov_b64 exec, -1
    s_waitcnt vmcnt(0)
    v_xor_b32 v10, v114, v4
    v_xor_b32 v11, v115, v5
    v_or_b32 v10, v10, v11
    v_cmp_eq_u32 vcc, 0, v10
    s_nop 1
    v_cndmask_b32 v80, v80, v112, vcc
    v_cndmask_b32 v81, v81, v113, vcc
    v_cndmask_b32 v82, v82, v114, vcc
    v_cndmask_b32 v83, v83, v115, vcc
    v_xor_b32 v10, v118, v4
    v_xor_b32 v11, v119, v5
    v_or_b32 v10, v10, v11
    v_cmp_eq_u32 vcc, 0, v10
    s_nop 1
    v_cndmask_b32 v84, v84, v116, vcc
    v_cndmask_b32 v85, v85, v117, vcc
    v_cndmask_b32 v86, v86, v118, vcc
    v_cndmask_b32 v87, v87, v119, vcc
    v_xor_b32 v10, v122, v4
    v_xor_b32 v11, v123, v5
    v_or_b32 v10, v10, v11
    v_cmp_eq_u32 vcc, 0, v10
    s_nop 1
    v_cndmask_b32 v88, v88, v120, vcc
    v_cndmask_b32 v89, v89, v121, vcc
    v_cndmask_b32 v90, v90, v122, vcc
    v_cndmask_b32 v91, v91, v123, vcc
    v_xor_b32 v10, v126, v4
    v_xor_b32 v11, v127, v5
    v_or_b32 v10, v10, v11
    v_cmp_eq_u32 vcc, 0, v10
    s_nop 1
    v_cndmask_b32 v92, v92, v124, vcc
    v_cndmask_b32 v93, v93, v125, vcc
    v_cndmask_b32 v94, v94, v126, vcc
    v_cndmask_b32 v95, v95, v127, vcc
    v_xor_b32 v10, v130, v4
    v_xor_b32 v11, v131, v5
    v_or_b32 v10, v10, v11
    v_cmp_eq_u32 vcc, 0, v10
    s_nop 1
    v_cndmask_b32 v96, v96, v128, vcc
    v_cndmask_b32 v97, v97, v129, vcc
    v_cndmask_b32 v98, v98, v130, vcc
    v_cndmask_b32 v99, v99, v131, vcc
    v_xor_b32 v10, v134, v4
    v_xor_b32 v11, v135, v5
    v_or_b32 v10, v10, v11
    v_cmp_eq_u32 vcc, 0, v10
    s_nop 1
    v_cndmask_b32 v100, v100, v132, vcc
    v_cndmask_b32 v101, v101, v133, vcc
    v_cndmask_b32 v102, v102, v134, vcc
    v_cndmask_b32 v103, v103, v135, vcc
    v_xor_b32 v10, v138, v4
    v_xor_b32 v11, v139, v5
    v_or_b32 v10, v10, v11
    v_cmp_eq_u32 vcc, 0, v10
    s_nop 1
    v_cndmask_b32 v104, v104, v136, vcc
    v_cndmask_b32 v105, v105, v137, vcc
    v_cndmask_b32 v106, v106, v138, vcc
    v_cndmask_b32 v107, v107, v139, vcc
    v_xor_b32 v10, v142, v4
    v_xor_b32 v11, v143, v5
    v_or_b32 v10, v10, v11
    v_cmp_eq_u32 vcc, 0, v10
    s_nop 1
    v_cndmask_b32 v108, v108, v140, vcc
    v_cndmask_b32 v109, v109, v141, vcc
    v_cndmask_b32 v110, v110, v142, vcc
    v_cndmask_b32 v111, v111, v143, vcc
    v_xor_b32 v11, v82, v4
    v_xor_b32 v3, v83, v5
    v_or_b32 v10, v11, v3
    v_xor_b32 v11, v86, v4
    v_xor_b32 v3, v87, v5
    v_or3_b32 v10, v10, v11, v3
    v_xor_b32 v11, v90, v4
    v_xor_b32 v3, v91, v5
    v_or3_b32 v10, v10, v11, v3
    v_xor_b32 v11, v94, v4
    v_xor_b32 v3, v95, v5
    v_or3_b32 v10, v10, v11, v3
    v_xor_b32 v11, v98, v4
    v_xor_b32 v3, v99, v5
    v_or3_b32 v10, v10, v11, v3
    v_xor_b32 v11, v102, v4
    v_xor_b32 v3, v103, v5
    v_or3_b32 v10, v10, v11, v3
    v_xor_b32 v11, v106, v4
    v_xor_b32 v3, v107, v5
    v_or3_b32 v10, v10, v11, v3
    v_xor_b32 v11, v110, v4
    v_xor_b32 v3, v111, v5
    v_or3_b32 v10, v10, v11, v3
    v_cmp_ne_u32 vcc, 0, v10
    s_cmp_lg_u64 vcc, 0
    s_cbranch_scc1 L_h_loop
L_h_done:
    v_lshlrev_b32 v9, 2, v1
    v_add_f32 v80, v80, v84
    v_add_f32 v88, v88, v92
    v_add_f32 v96, v96, v100
    v_add_f32 v104, v104, v108
    v_add_f32 v80, v80, v88
    v_add_f32 v96, v96, v104
    v_add_f32 v80, v80, v96
    v_max_f32 v80, 0, v80
    v_add_f32 v81, v81, v85
    v_add_f32 v89, v89, v93
    v_add_f32 v97, v97, v101
    v_add_f32 v105, v105, v109
    v_add_f32 v81, v81, v89
    v_add_f32 v97, v97, v105
    v_add_f32 v81, v81, v97
    v_max_f32 v81, 0, v81
    v_cvt_pk_bf16_f32 v82, v80, v81
    s_mov_b64 exec, 0xfffffff
    ds_write_b32 v9, v82 offset:3200
    s_mov_b64 exec, -1
    v_and_b32 v12, 7, v1
    v_lshrrev_b32 v13, 3, v1
    v_lshlrev_b32 v14, 9, v13
    v_lshl_add_u32 v14, v12, 4, v14
    s_lshl_b32 s9, s2, 12
    s_add_u32 s9, s9, 1048576
    v_add_u32 v14, s9, v14
    s_lshl_b32 s9, s47, 9
    s_add_u32 s9, s9, 262144
    v_lshlrev_b32 v15, 6, v13
    v_add_u32 v15, s9, v15
    v_add_u32 v108, 0x200000, v14
    v_add_u32 v109, 0x200000, v15
    s_waitcnt lgkmcnt(0)
    s_barrier
    s_mov_b32 s42, 400000
L_o_loop:
    global_load_dwordx4 v[32:35], v15, s[36:37] offset:0 sc1
    global_load_dwordx4 v[36:39], v15, s[36:37] offset:16 sc1
    global_load_dwordx4 v[40:43], v15, s[36:37] offset:32 sc1
    global_load_dwordx4 v[44:47], v15, s[36:37] offset:48 sc1
    global_load_dwordx4 v[16:19], v14, s[36:37] offset:0 sc1
    global_load_dwordx4 v[20:23], v14, s[36:37] offset:128 sc1
    global_load_dwordx4 v[24:27], v14, s[36:37] offset:256 sc1
    global_load_dwordx4 v[28:31], v14, s[36:37] offset:384 sc1
    s_waitcnt vmcnt(0)
    v_xor_b32 v11, v34, v4
    v_xor_b32 v3, v35, v5
    v_or_b32 v10, v11, v3
    v_xor_b32 v11, v38, v4
    v_xor_b32 v3, v39, v5
    v_or3_b32 v10, v10, v11, v3
    v_xor_b32 v11, v42, v4
    v_xor_b32 v3, v43, v5
    v_or3_b32 v10, v10, v11, v3
    v_xor_b32 v11, v46, v4
    v_xor_b32 v3, v47, v5
    v_or3_b32 v10, v10, v11, v3
    v_xor_b32 v11, v18, v4
    v_xor_b32 v3, v19, v5
    v_or3_b32 v10, v10, v11, v3
    v_xor_b32 v11, v22, v4
    v_xor_b32 v3, v23, v5
    v_or3_b32 v10, v10, v11, v3
    v_xor_b32 v11, v26, v4
    v_xor_b32 v3, v27, v5
    v_or3_b32 v10, v10, v11, v3
    v_xor_b32 v11, v30, v4
    v_xor_b32 v3, v31, v5
    v_or3_b32 v10, v10, v11, v3
    v_cmp_ne_u32 vcc, 0, v10
    s_sub_u32 s42, s42, 1
    s_cbranch_scc1 L_o_done
    s_cmp_eq_u64 vcc, 0
    s_cbranch_scc1 L_o_done
    s_and_b32 s11, s42, 15
    s_cbranch_scc1 L_o_loop
    global_load_dwordx4 v[80:83], v109, s[36:37] offset:0 sc1
    global_load_dwordx4 v[84:87], v109, s[36:37] offset:16 sc1
    global_load_dwordx4 v[88:91], v109, s[36:37] offset:32 sc1
    global_load_dwordx4 v[92:95], v109, s[36:37] offset:48 sc1
    global_load_dwordx4 v[64:67], v108, s[36:37] offset:0 sc1
    global_load_dwordx4 v[68:71], v108, s[36:37] offset:128 sc1
    global_load_dwordx4 v[72:75], v108, s[36:37] offset:256 sc1
    global_load_dwordx4 v[76:79], v108, s[36:37] offset:384 sc1
    s_waitcnt vmcnt(0)
    v_xor_b32 v10, v82, v4
    v_xor_b32 v11, v83, v5
    v_or_b32 v10, v10, v11
    v_cmp_eq_u32 vcc, 0, v10
    s_nop 1
    v_cndmask_b32 v32, v32, v80, vcc
    v_cndmask_b32 v33, v33, v81, vcc
    v_cndmask_b32 v34, v34, v82, vcc
    v_cndmask_b32 v35, v35, v83, vcc
    v_xor_b32 v10, v86, v4
    v_xor_b32 v11, v87, v5
    v_or_b32 v10, v10, v11
    v_cmp_eq_u32 vcc, 0, v10
    s_nop 1
    v_cndmask_b32 v36, v36, v84, vcc
    v_cndmask_b32 v37, v37, v85, vcc
    v_cndmask_b32 v38, v38, v86, vcc
    v_cndmask_b32 v39, v39, v87, vcc
    v_xor_b32 v10, v90, v4
    v_xor_b32 v11, v91, v5
    v_or_b32 v10, v10, v11
    v_cmp_eq_u32 vcc, 0, v10
    s_nop 1
    v_cndmask_b32 v40, v40, v88, vcc
    v_cndmask_b32 v41, v41, v89, vcc
    v_cndmask_b32 v42, v42, v90, vcc
    v_cndmask_b32 v43, v43, v91, vcc
    v_xor_b32 v10, v94, v4
    v_xor_b32 v11, v95, v5
    v_or_b32 v10, v10, v11
    v_cmp_eq_u32 vcc, 0, v10
    s_nop 1
    v_cndmask_b32 v44, v44, v92, vcc
    v_cndmask_b32 v45, v45, v93, vcc
    v_cndmask_b32 v46, v46, v94, vcc
    v_cndmask_b32 v47, v47, v95, vcc
    v_xor_b32 v10, v66, v4
    v_xor_b32 v11, v67, v5
    v_or_b32 v10, v10, v11
    v_cmp_eq_u32 vcc, 0, v10
    s_nop 1
    v_cndmask_b32 v16, v16, v64, vcc
    v_cndmask_b32 v17, v17, v65, vcc
    v_cndmask_b32 v18, v18, v66, vcc
    v_cndmask_b32 v19, v19, v67, vcc
    v_xor_b32 v10, v70, v4
    v_xor_b32 v11, v71, v5
    v_or_b32 v10, v10, v11
    v_cmp_eq_u32 vcc, 0, v10
    s_nop 1
    v_cndmask_b32 v20, v20, v68, vcc
    v_cndmask_b32 v21, v21, v69, vcc
    v_cndmask_b32 v22, v22, v70, vcc
    v_cndmask_b32 v23, v23, v71, vcc
    v_xor_b32 v10, v74, v4
    v_xor_b32 v11, v75, v5
    v_or_b32 v10, v10, v11
    v_cmp_eq_u32 vcc, 0, v10
    s_nop 1
    v_cndmask_b32 v24, v24, v72, vcc
    v_cndmask_b32 v25, v25, v73, vcc
    v_cndmask_b32 v26, v26, v74, vcc
    v_cndmask_b32 v27, v27, v75, vcc
    v_xor_b32 v10, v78, v4
    v_xor_b32 v11, v79, v5
    v_or_b32 v10, v10, v11
    v_cmp_eq_u32 vcc, 0, v10
    s_nop 1
    v_cndmask_b32 v28, v28, v76, vcc
    v_cndmask_b32 v29, v29, v77, vcc
    v_cndmask_b32 v30, v30, v78, vcc
    v_cndmask_b32 v31, v31, v79, vcc
    v_xor_b32 v11, v34, v4
    v_xor_b32 v3, v35, v5
    v_or_b32 v10, v11, v3
    v_xor_b32 v11, v38, v4
    v_xor_b32 v3, v39, v5
    v_or3_b32 v10, v10, v11, v3
    v_xor_b32 v11, v42, v4
    v_xor_b32 v3, v43, v5
    v_or3_b32 v10, v10, v11, v3
    v_xor_b32 v11, v46, v4
    v_xor_b32 v3, v47, v5
    v_or3_b32 v10, v10, v11, v3
    v_xor_b32 v11, v18, v4
    v_xor_b32 v3, v19, v5
    v_or3_b32 v10, v10, v11, v3
    v_xor_b32 v11, v22, v4
    v_xor_b32 v3, v23, v5
    v_or3_b32 v10, v10, v11, v3
    v_xor_b32 v11, v26, v4
    v_xor_b32 v3, v27, v5
    v_or3_b32 v10, v10, v11, v3
    v_xor_b32 v11, v30, v4
    v_xor_b32 v3, v31, v5
    v_or3_b32 v10, v10, v11, v3
    v_cmp_ne_u32 vcc, 0, v10
    s_cmp_lg_u64 vcc, 0
    s_cbranch_scc1 L_o_loop
L_o_done:
    v_max_f32 v48, v32, v36
    v_max3_f32 v48, v48, v40, v44
    s_nop 1
    v_max_f32_dpp v48, v48, v48 row_ror:8 row_mask:0xf bank_mask:0xf
    v_mov_b32 v244, v48
    s_nop 1
    v_permlane16_swap_b32 v48, v244
    s_nop 0
    v_max_f32 v48, v48, v244
    v_mov_b32 v244, v48
    s_nop 1
    v_permlane32_swap_b32 v48, v244
    s_nop 0
    v_max_f32 v48, v48, v244
    v_sub_f32 v49, v32, v48
    v_mul_f32 v49, s43, v49
    v_sub_f32 v50, v36, v48
    v_mul_f32 v50, s43, v50
    v_sub_f32 v51, v40, v48
    v_mul_f32 v51, s43, v51
    v_sub_f32 v52, v44, v48
    v_mul_f32 v52, s43, v52
    v_exp_f32 v49, v49
    v_exp_f32 v50, v50
    v_exp_f32 v51, v51
    v_exp_f32 v52, v52
    s_nop 0
    v_mul_f32 v53, v49, v33
    v_mul_f32 v54, v49, v16
    v_mul_f32 v55, v49, v17
    v_fmac_f32 v53, v50, v37
    v_fmac_f32 v54, v50, v20
    v_fmac_f32 v55, v50, v21
    v_fmac_f32 v53, v51, v41
    v_fmac_f32 v54, v51, v24
    v_fmac_f32 v55, v51, v25
    v_fmac_f32 v53, v52, v45
    v_fmac_f32 v54, v52, v28
    v_fmac_f32 v55, v52, v29
    s_nop 1
    v_add_f32_dpp v53, v53, v53 row_ror:8 row_mask:0xf bank_mask:0xf
    v_add_f32_dpp v54, v54, v54 row_ror:8 row_mask:0xf bank_mask:0xf
    v_add_f32_dpp v55, v55, v55 row_ror:8 row_mask:0xf bank_mask:0xf
    v_mov_b32 v244, v53
    v_mov_b32 v245, v54
    v_mov_b32 v246, v55
    s_nop 1
    v_permlane16_swap_b32 v53, v244
    v_permlane16_swap_b32 v54, v245
    v_permlane16_swap_b32 v55, v246
    s_nop 0
    v_add_f32 v53, v53, v244
    v_add_f32 v54, v54, v245
    v_add_f32 v55, v55, v246
    v_mov_b32 v244, v53
    v_mov_b32 v245, v54
    v_mov_b32 v246, v55
    s_nop 1
    v_permlane32_swap_b32 v53, v244
    v_permlane32_swap_b32 v54, v245
    v_permlane32_swap_b32 v55, v246
    s_nop 0
    v_add_f32 v53, v53, v244
    v_add_f32 v54, v54, v245
    v_add_f32 v55, v55, v246
    v_rcp_f32 v56, v53
    s_nop 0
    v_mul_f32 v57, v54, v56
    v_fma_f32 v58, -v57, v53, v54
    v_fma_f32 v54, v58, v56, v57
    v_mul_f32 v57, v55, v56
    v_fma_f32 v58, -v57, v53, v55
    v_fma_f32 v55, v58, v56, v57
    v_cvt_pk_bf16_f32 v60, v54, v55
    s_nop 1
    v_mov_b32_dpp v61, v60 quad_perm:[1,0,3,2] row_mask:0xf bank_mask:0xf
    v_mov_b32 v62, v4
    v_mov_b32 v63, v5
    s_lshl_b32 s9, s4, 11
    s_lshl_b32 s10, s5, 6
    s_add_u32 s9, s9, s10
    s_add_u32 s9, s9, 294912
    v_lshlrev_b32 v7, 3, v1
    v_add_u32 v7, s9, v7
    s_mov_b64 exec, 0x55
    v_add_u32 v110, 0x200000, v7
    global_store_dwordx4 v7, v[60:63], s[36:37]
    global_store_dwordx4 v110, v[60:63], s[36:37] sc1
    s_mov_b64 exec, -1
    s_lshl_b32 s9, s47, 9
    s_add_u32 s9, s9, 294912
    v_and_b32 v13, 31, v1
    v_lshlrev_b32 v13, 4, v13
    v_add_u32 v13, s9, v13
    v_add_u32 v108, 0x200000, v13
    s_mov_b32 s42, 400000
L_ob_loop:
    global_load_dwordx4 v[32:35], v13, s[36:37] sc1
    s_waitcnt vmcnt(0)
    v_xor_b32 v11, v34, v4
    v_xor_b32 v3, v35, v5
    v_or_b32 v10, v11, v3
    v_cmp_ne_u32 vcc, 0, v10
    s_sub_u32 s42, s42, 1
    s_cbranch_scc1 L_ob_done
    s_cmp_eq_u64 vcc, 0
    s_cbranch_scc1 L_ob_done
    s_and_b32 s11, s42, 15
    s_cbranch_scc1 L_ob_loop
    global_load_dwordx4 v[64:67], v108, s[36:37] sc1
    s_waitcnt vmcnt(0)
    v_xor_b32 v10, v66, v4
    v_xor_b32 v11, v67, v5
    v_or_b32 v10, v10, v11
    v_cmp_eq_u32 vcc, 0, v10
    s_nop 1
    v_cndmask_b32 v32, v32, v64, vcc
    v_cndmask_b32 v33, v33, v65, vcc
    v_cndmask_b32 v34, v34, v66, vcc
    v_cndmask_b32 v35, v35, v67, vcc
    v_xor_b32 v11, v34, v4
    v_xor_b32 v3, v35, v5
    v_or_b32 v10, v11, v3
    v_cmp_ne_u32 vcc, 0, v10
    s_cmp_lg_u64 vcc, 0
    s_cbranch_scc1 L_ob_loop
L_ob_done:
    v_and_b32 v7, 31, v1
    v_lshlrev_b32 v7, 3, v7
    ds_write_b64 v7, v[32:33] offset:3328
    s_lshl_b32 s9, s46, 15
    s_lshl_b32 s10, s47, 4
    s_add_u32 s9, s9, s10
    s_add_u32 s9, s9, 524288
    v_lshlrev_b32 v12, 9, v1
    v_add_u32 v12, s9, v12
    s_lshl_b32 s9, s2, 10
    s_add_u32 s9, s9, 524288
    v_lshlrev_b32 v9, 4, v1
    v_add_u32 v9, s9, v9
    v_lshlrev_b32 v7, 2, v1
    s_waitcnt lgkmcnt(0)
    s_barrier
    s_barrier
    ds_read_b32 v20, v7 offset:3712
    ds_read_b32 v24, v7 offset:4736
    ds_read_b32 v21, v7 offset:3968
    ds_read_b32 v25, v7 offset:4992
    ds_read_b32 v22, v7 offset:4224
    ds_read_b32 v26, v7 offset:5248
    ds_read_b32 v23, v7 offset:4480
    ds_read_b32 v27, v7 offset:5504
    s_waitcnt lgkmcnt(0)
    v_add_f32 v16, v20, v21
    v_add_f32 v17, v24, v25
    v_add_f32 v22, v22, v23
    v_add_f32 v26, v26, v27
    v_add_f32 v16, v16, v22
    v_add_f32 v17, v17, v26
    v_mov_b32 v18, v4
    v_mov_b32 v19, v5
    global_store_dwordx4 v12, v[16:19], s[36:37] sc1
    s_mov_b32 s42, 400000
L_f_loop:
    global_load_dwordx4 v[32:35], v9, s[36:37] sc1
    s_waitcnt vmcnt(0)
    v_xor_b32 v11, v34, v4
    v_xor_b32 v3, v35, v5
    v_or_b32 v10, v11, v3
    v_cmp_ne_u32 vcc, 0, v10
    s_sub_u32 s42, s42, 1
    s_cbranch_scc1 L_f_done
    s_cmp_eq_u64 vcc, 0
    s_cbranch_scc1 L_f_done
    s_branch L_f_loop
L_f_done:
    s_nop 1
    v_add_f32_dpp v32, v32, v32 row_ror:8 row_mask:0xf bank_mask:0xf
    v_add_f32_dpp v33, v33, v33 row_ror:8 row_mask:0xf bank_mask:0xf
    s_nop 0
    v_add_f32_dpp v32, v32, v32 row_ror:4 row_mask:0xf bank_mask:0xf
    v_add_f32_dpp v33, v33, v33 row_ror:4 row_mask:0xf bank_mask:0xf
    s_nop 0
    v_add_f32_dpp v32, v32, v32 row_ror:2 row_mask:0xf bank_mask:0xf
    v_add_f32_dpp v33, v33, v33 row_ror:2 row_mask:0xf bank_mask:0xf
    s_nop 0
    v_add_f32_dpp v32, v32, v32 row_ror:1 row_mask:0xf bank_mask:0xf
    v_add_f32_dpp v33, v33, v33 row_ror:1 row_mask:0xf bank_mask:0xf
    s_nop 0
    v_mov_b32 v244, v32
    v_mov_b32 v245, v33
    s_nop 1
    v_permlane16_swap_b32 v32, v244
    v_permlane16_swap_b32 v33, v245
    s_nop 0
    v_add_f32 v32, v32, v244
    v_add_f32 v33, v33, v245
    v_cvt_pk_bf16_f32 v36, v32, v33
    v_lshlrev_b32 v32, 16, v36
    v_and_b32 v33, s15, v36
    v_lshlrev_b32 v37, 16, v8
    v_and_b32 v38, s15, v8
    v_cmp_gt_u32 vcc, 32, v1
    s_nop 1
    v_cndmask_b32 v37, v38, v37, vcc
    v_add_f32 v32, v32, v37
    v_cvt_pk_bf16_f32 v36, v32, v32
    v_lshlrev_b32 v32, 16, v36
    v_add_f32 v32, v32, v33
    v_cvt_pk_bf16_f32 v36, v32, v32
    v_lshrrev_b32 v7, 5, v1
    v_lshlrev_b32 v7, 1, v7
    v_add_u32 v7, s12, v7
    s_mov_b32 exec_lo, 1
    s_mov_b32 exec_hi, 1
    global_store_short v7, v36, s[32:33]
L_end:
    s_endpgm
.section .rodata,"a"
.p2align 6
.amdhsa_kernel parallel_sum__sliding_block_cached__dense_activation_relu__decode_kernel
  .amdhsa_next_free_vgpr 256
  .amdhsa_next_free_sgpr 64
  .amdhsa_accum_offset 256
  .amdhsa_group_segment_fixed_size 0
  .amdhsa_kernarg_size 88
  .amdhsa_user_sgpr_count 2
  .amdhsa_user_sgpr_kernarg_segment_ptr 1
  .amdhsa_system_sgpr_workgroup_id_x 1
  .amdhsa_float_denorm_mode_32 3
.end_amdhsa_kernel
```
